```python
import torch

def _softmax(x, axis=-1):
    return torch.softmax(x, dim=axis)
def _gelu(x):
    return torch.nn.functional.gelu(x, approximate="tanh")
def _silu(x):
    return torch.nn.functional.silu(x)
def _sigmoid(x):
    return torch.sigmoid(x)
def _layernorm(x, axis=-1, eps=1e-5):
    m = x.mean(dim=axis, keepdim=True)
    v = x.var(dim=axis, keepdim=True, unbiased=False)
    return (x - m) / torch.sqrt(v + eps)
def _scatter_add(tgt, idx, src, axis=0):
    return tgt.clone().index_add_(axis, idx, src)
def _segment_sum(src, seg, n):
    out = torch.zeros((n,) + src.shape[1:], dtype=src.dtype)
    return out.index_add_(0, seg, src)
def _pad(x, pw):
    flat = tuple(v for pair in reversed(pw) for v in pair)
    return torch.nn.functional.pad(x, flat)

kernel_name = 'standalone__grn__sampling'

def setup_inputs():

    _w = (lambda a: (lambda t: t.to(torch.bfloat16) if t.is_floating_point() else t)(torch.as_tensor(a)))
    B, S, D = 1024, 8, 640
    return {
        "x": _w((lambda *s: torch.randn(*s, dtype=torch.bfloat16) * 0.05)(B, S, D)),
        "g": _w((lambda *s: torch.randn(*s, dtype=torch.bfloat16) * 0.4)(D) * 0.1),
        "b": _w((lambda *s: torch.randn(*s, dtype=torch.bfloat16) * 0.1)(D) * 0.1),
    }

def reference(x, g, b):
    gx = torch.sqrt((x * x).sum(axis=-2, keepdims=True))
    nx = gx / (gx.mean(axis=-1, keepdims=True) + 1e-6)
    return g * (x * nx) + b + x
```

```asm
; @launch grid=(256,1,1) block=(256,1,1) lds=0
.amdgcn_target "amdgcn-amd-amdhsa--gfx950"
.text
.globl standalone__grn__sampling_kernel
.p2align 12
.p2align 8
.type standalone__grn__sampling_kernel,@function
standalone__grn__sampling_kernel:
    s_load_dwordx8 s[4:11], s[0:1], 0
    s_cmp_ge_u32 s2, 256
    s_cbranch_scc1 L_end
    s_mul_i32 s3, s2, 40960
    v_and_b32 v4, 63, v0
    v_lshrrev_b32 v1, 6, v0
    v_mul_u32_u24 v1, 10240, v1
    v_add_u32 v6, s3, v1
    v_lshrrev_b32 v3, 4, v4
    v_and_b32 v5, 15, v0
    v_lshlrev_b32 v4, 4, v4
    v_lshlrev_b32 v5, 4, v5
    v_mul_u32_u24 v3, 1280, v3
    v_add_u32 v1, v6, v4
    v_add_u32 v5, 1024, v5
    v_add_u32 v2, 5120, v1
    v_add3_u32 v3, v3, v5, v6
    v_add_u32 v3, 2560, v3
    s_cmp_eq_u32 0, 0
    s_branch L_hop1
L_back1:
    s_waitcnt lgkmcnt(0)
    global_load_dwordx4 v[8:11], v3, s[4:5] offset:-2560 nt
    global_load_dwordx4 v[88:91], v4, s[6:7]
    global_load_dwordx4 v[92:95], v5, s[6:7]
    global_load_dwordx4 v[100:103], v5, s[8:9]
    global_load_dwordx4 v[12:15], v3, s[4:5] offset:2560 nt
    global_load_dwordx4 v[16:19], v1, s[4:5] offset:0 nt
    global_load_dwordx4 v[20:23], v1, s[4:5] offset:1280 nt
    global_load_dwordx4 v[24:27], v1, s[4:5] offset:2560 nt
    global_load_dwordx4 v[28:31], v1, s[4:5] offset:3840 nt
    global_load_dwordx4 v[32:35], v2, s[4:5] offset:0 nt
    global_load_dwordx4 v[36:39], v2, s[4:5] offset:1280 nt
    global_load_dwordx4 v[40:43], v2, s[4:5] offset:2560 nt
    global_load_dwordx4 v[44:47], v2, s[4:5] offset:3840 nt
    s_branch L_hop2
L_back2:
    s_cmp_lg_u32 0, 0
    s_mov_b32 s12, 0xffff0000
    s_mov_b32 s13, 0x3acccccd
    v_mov_b32 v7, 0x358637bd
    s_waitcnt vmcnt(12)
    v_lshlrev_b32 v48, 16, v8
    v_lshlrev_b32 v49, 16, v9
    v_lshlrev_b32 v50, 16, v10
    v_lshlrev_b32 v51, 16, v11
    v_and_b32 v8, s12, v8
    v_and_b32 v9, s12, v9
    v_and_b32 v10, s12, v10
    v_and_b32 v11, s12, v11
    v_pk_mul_f32 v[132:133], v[48:49], v[48:49]
    v_pk_mul_f32 v[134:135], v[50:51], v[50:51]
    v_pk_mul_f32 v[128:129], v[8:9], v[8:9]
    v_pk_mul_f32 v[130:131], v[10:11], v[10:11]
    s_waitcnt vmcnt(9)
    v_lshlrev_b32 v104, 16, v88
    v_lshlrev_b32 v105, 16, v89
    v_lshlrev_b32 v106, 16, v90
    v_lshlrev_b32 v107, 16, v91
    v_and_b32 v88, s12, v88
    v_and_b32 v89, s12, v89
    v_and_b32 v90, s12, v90
    v_and_b32 v91, s12, v91
    v_lshlrev_b32 v108, 16, v92
    v_lshlrev_b32 v109, 16, v93
    v_lshlrev_b32 v110, 16, v94
    v_lshlrev_b32 v111, 16, v95
    v_and_b32 v92, s12, v92
    v_and_b32 v93, s12, v93
    v_and_b32 v94, s12, v94
    v_and_b32 v95, s12, v95
    v_lshlrev_b32 v116, 16, v100
    v_lshlrev_b32 v117, 16, v101
    v_lshlrev_b32 v118, 16, v102
    v_lshlrev_b32 v119, 16, v103
    v_and_b32 v100, s12, v100
    v_and_b32 v101, s12, v101
    v_and_b32 v102, s12, v102
    v_and_b32 v103, s12, v103
    s_waitcnt vmcnt(8)
    v_lshlrev_b32 v52, 16, v12
    v_lshlrev_b32 v53, 16, v13
    v_lshlrev_b32 v54, 16, v14
    v_lshlrev_b32 v55, 16, v15
    v_and_b32 v12, s12, v12
    v_and_b32 v13, s12, v13
    v_and_b32 v14, s12, v14
    v_and_b32 v15, s12, v15
    v_pk_fma_f32 v[132:133], v[52:53], v[52:53], v[132:133]
    v_pk_fma_f32 v[134:135], v[54:55], v[54:55], v[134:135]
    v_pk_fma_f32 v[128:129], v[12:13], v[12:13], v[128:129]
    v_pk_fma_f32 v[130:131], v[14:15], v[14:15], v[130:131]
    s_nop 1
    v_permlane32_swap_b32 v128, v132
    v_permlane32_swap_b32 v129, v133
    v_permlane32_swap_b32 v130, v134
    v_permlane32_swap_b32 v131, v135
    v_pk_add_f32 v[128:129], v[128:129], v[132:133]
    v_pk_add_f32 v[130:131], v[130:131], v[134:135]
    s_nop 1
    v_permlane16_swap_b32 v128, v130
    v_permlane16_swap_b32 v129, v131
    v_pk_add_f32 v[128:129], v[128:129], v[130:131]
    v_sqrt_f32 v128, v128
    v_sqrt_f32 v129, v129
    s_nop 0
    v_add_f32 v136, v128, v129
    v_mov_b32 v130, v128
    v_mov_b32 v131, v129
    s_nop 1
    v_permlane16_swap_b32 v128, v130
    v_permlane16_swap_b32 v129, v131
    v_mov_b32 v132, v128
    v_mov_b32 v133, v129
    v_mov_b32 v134, v130
    v_mov_b32 v135, v131
    s_nop 1
    v_permlane32_swap_b32 v128, v132
    v_permlane32_swap_b32 v129, v133
    v_permlane32_swap_b32 v130, v134
    v_permlane32_swap_b32 v131, v135
    s_waitcnt vmcnt(7)
    v_lshlrev_b32 v56, 16, v16
    v_lshlrev_b32 v57, 16, v17
    v_lshlrev_b32 v58, 16, v18
    v_lshlrev_b32 v59, 16, v19
    v_and_b32 v16, s12, v16
    v_and_b32 v17, s12, v17
    v_and_b32 v18, s12, v18
    v_and_b32 v19, s12, v19
    v_pk_mul_f32 v[124:125], v[56:57], v[56:57]
    v_pk_mul_f32 v[126:127], v[58:59], v[58:59]
    v_pk_mul_f32 v[120:121], v[16:17], v[16:17]
    v_pk_mul_f32 v[122:123], v[18:19], v[18:19]
    s_waitcnt vmcnt(6)
    v_lshlrev_b32 v60, 16, v20
    v_lshlrev_b32 v61, 16, v21
    v_lshlrev_b32 v62, 16, v22
    v_lshlrev_b32 v63, 16, v23
    v_and_b32 v20, s12, v20
    v_and_b32 v21, s12, v21
    v_and_b32 v22, s12, v22
    v_and_b32 v23, s12, v23
    v_pk_fma_f32 v[124:125], v[60:61], v[60:61], v[124:125]
    v_pk_fma_f32 v[126:127], v[62:63], v[62:63], v[126:127]
    v_pk_fma_f32 v[120:121], v[20:21], v[20:21], v[120:121]
    v_pk_fma_f32 v[122:123], v[22:23], v[22:23], v[122:123]
    s_waitcnt vmcnt(5)
    v_lshlrev_b32 v64, 16, v24
    v_lshlrev_b32 v65, 16, v25
    v_lshlrev_b32 v66, 16, v26
    v_lshlrev_b32 v67, 16, v27
    v_and_b32 v24, s12, v24
    v_and_b32 v25, s12, v25
    v_and_b32 v26, s12, v26
    v_and_b32 v27, s12, v27
    v_pk_fma_f32 v[124:125], v[64:65], v[64:65], v[124:125]
    v_pk_fma_f32 v[126:127], v[66:67], v[66:67], v[126:127]
    v_pk_fma_f32 v[120:121], v[24:25], v[24:25], v[120:121]
    v_pk_fma_f32 v[122:123], v[26:27], v[26:27], v[122:123]
    s_waitcnt vmcnt(4)
    global_load_dwordx4 v[96:99], v4, s[8:9]
    v_lshlrev_b32 v68, 16, v28
    v_lshlrev_b32 v69, 16, v29
    v_lshlrev_b32 v70, 16, v30
    v_lshlrev_b32 v71, 16, v31
    v_and_b32 v28, s12, v28
    v_and_b32 v29, s12, v29
    v_and_b32 v30, s12, v30
    v_and_b32 v31, s12, v31
    v_pk_fma_f32 v[124:125], v[68:69], v[68:69], v[124:125]
    v_pk_fma_f32 v[126:127], v[70:71], v[70:71], v[126:127]
    v_pk_fma_f32 v[120:121], v[28:29], v[28:29], v[120:121]
    v_pk_fma_f32 v[122:123], v[30:31], v[30:31], v[122:123]
    s_waitcnt vmcnt(4)
    v_lshlrev_b32 v72, 16, v32
    v_lshlrev_b32 v73, 16, v33
    v_lshlrev_b32 v74, 16, v34
    v_lshlrev_b32 v75, 16, v35
    v_and_b32 v32, s12, v32
    v_and_b32 v33, s12, v33
    v_and_b32 v34, s12, v34
    v_and_b32 v35, s12, v35
    v_pk_fma_f32 v[124:125], v[72:73], v[72:73], v[124:125]
    v_pk_fma_f32 v[126:127], v[74:75], v[74:75], v[126:127]
    v_pk_fma_f32 v[120:121], v[32:33], v[32:33], v[120:121]
    v_pk_fma_f32 v[122:123], v[34:35], v[34:35], v[122:123]
    s_waitcnt vmcnt(3)
    v_lshlrev_b32 v76, 16, v36
    v_lshlrev_b32 v77, 16, v37
    v_lshlrev_b32 v78, 16, v38
    v_lshlrev_b32 v79, 16, v39
    v_and_b32 v36, s12, v36
    v_and_b32 v37, s12, v37
    v_and_b32 v38, s12, v38
    v_and_b32 v39, s12, v39
    v_pk_fma_f32 v[124:125], v[76:77], v[76:77], v[124:125]
    v_pk_fma_f32 v[126:127], v[78:79], v[78:79], v[126:127]
    v_pk_fma_f32 v[120:121], v[36:37], v[36:37], v[120:121]
L_hop1:
    s_cbranch_scc1 L_back1
    v_pk_fma_f32 v[122:123], v[38:39], v[38:39], v[122:123]
    s_waitcnt vmcnt(2)
    v_lshlrev_b32 v80, 16, v40
    v_lshlrev_b32 v81, 16, v41
    v_lshlrev_b32 v82, 16, v42
    v_lshlrev_b32 v83, 16, v43
    v_and_b32 v40, s12, v40
    v_and_b32 v41, s12, v41
    v_and_b32 v42, s12, v42
    v_and_b32 v43, s12, v43
    v_pk_fma_f32 v[124:125], v[80:81], v[80:81], v[124:125]
    v_pk_fma_f32 v[126:127], v[82:83], v[82:83], v[126:127]
    v_pk_fma_f32 v[120:121], v[40:41], v[40:41], v[120:121]
    v_pk_fma_f32 v[122:123], v[42:43], v[42:43], v[122:123]
    s_waitcnt vmcnt(1)
    v_lshlrev_b32 v84, 16, v44
    v_lshlrev_b32 v85, 16, v45
    v_lshlrev_b32 v86, 16, v46
    v_lshlrev_b32 v87, 16, v47
    v_and_b32 v44, s12, v44
    v_and_b32 v45, s12, v45
    v_and_b32 v46, s12, v46
    v_and_b32 v47, s12, v47
    v_pk_fma_f32 v[124:125], v[84:85], v[84:85], v[124:125]
    v_pk_fma_f32 v[126:127], v[86:87], v[86:87], v[126:127]
    v_pk_fma_f32 v[120:121], v[44:45], v[44:45], v[120:121]
    v_pk_fma_f32 v[122:123], v[46:47], v[46:47], v[122:123]
    v_sqrt_f32 v124, v124
    v_sqrt_f32 v125, v125
    v_sqrt_f32 v126, v126
    v_sqrt_f32 v127, v127
    v_sqrt_f32 v120, v120
    v_sqrt_f32 v121, v121
    v_sqrt_f32 v122, v122
    v_sqrt_f32 v123, v123
    v_pk_add_f32 v[138:139], v[124:125], v[126:127]
    v_pk_add_f32 v[140:141], v[120:121], v[122:123]
    v_pk_add_f32 v[138:139], v[138:139], v[140:141]
    v_add_f32 v136, v136, v138
    v_add_f32 v136, v136, v139
    v_pk_mul_f32 v[124:125], v[124:125], v[104:105]
    v_pk_mul_f32 v[126:127], v[126:127], v[106:107]
    v_add_f32_dpp v136, v136, v136 quad_perm:[1,0,3,2] row_mask:0xf bank_mask:0xf
    v_pk_mul_f32 v[120:121], v[120:121], v[88:89]
    v_pk_mul_f32 v[122:123], v[122:123], v[90:91]
    v_add_f32_dpp v136, v136, v136 quad_perm:[2,3,0,1] row_mask:0xf bank_mask:0xf
    v_pk_mul_f32 v[132:133], v[132:133], v[108:109]
    v_pk_mul_f32 v[134:135], v[134:135], v[110:111]
    v_add_f32_dpp v136, v136, v136 row_half_mirror row_mask:0xf bank_mask:0xf
    v_pk_mul_f32 v[128:129], v[128:129], v[92:93]
    v_pk_mul_f32 v[130:131], v[130:131], v[94:95]
    v_add_f32_dpp v136, v136, v136 row_mirror row_mask:0xf bank_mask:0xf
    v_mov_b32 v137, v136
    s_nop 1
    v_permlane16_swap_b32 v136, v137
    v_add_f32 v136, v136, v137
    v_mov_b32 v137, v136
    s_nop 1
    v_permlane32_swap_b32 v136, v137
    v_add_f32 v136, v136, v137
    v_fma_f32 v136, v136, s13, v7
    v_rcp_f32 v136, v136
    s_nop 0
    v_pk_fma_f32 v[124:125], v[124:125], v[136:137], 1.0 op_sel_hi:[1,0,0]
    v_pk_fma_f32 v[126:127], v[126:127], v[136:137], 1.0 op_sel_hi:[1,0,0]
    v_pk_fma_f32 v[120:121], v[120:121], v[136:137], 1.0 op_sel_hi:[1,0,0]
    v_pk_fma_f32 v[122:123], v[122:123], v[136:137], 1.0 op_sel_hi:[1,0,0]
    v_pk_fma_f32 v[132:133], v[132:133], v[136:137], 1.0 op_sel_hi:[1,0,0]
    v_pk_fma_f32 v[134:135], v[134:135], v[136:137], 1.0 op_sel_hi:[1,0,0]
    v_pk_fma_f32 v[128:129], v[128:129], v[136:137], 1.0 op_sel_hi:[1,0,0]
    v_pk_fma_f32 v[130:131], v[130:131], v[136:137], 1.0 op_sel_hi:[1,0,0]
    s_waitcnt vmcnt(0)
    v_lshlrev_b32 v112, 16, v96
    v_lshlrev_b32 v113, 16, v97
    v_lshlrev_b32 v114, 16, v98
    v_lshlrev_b32 v115, 16, v99
    v_and_b32 v96, s12, v96
    v_and_b32 v97, s12, v97
    v_and_b32 v98, s12, v98
    v_and_b32 v99, s12, v99
    v_pk_fma_f32 v[56:57], v[56:57], v[124:125], v[112:113]
    v_pk_fma_f32 v[16:17], v[16:17], v[120:121], v[96:97]
    v_pk_fma_f32 v[58:59], v[58:59], v[126:127], v[114:115]
    v_pk_fma_f32 v[18:19], v[18:19], v[122:123], v[98:99]
    v_cvt_pk_bf16_f32 v16, v56, v16
    v_cvt_pk_bf16_f32 v17, v57, v17
    v_cvt_pk_bf16_f32 v18, v58, v18
    v_cvt_pk_bf16_f32 v19, v59, v19
    global_store_dwordx4 v1, v[16:19], s[10:11] offset:0 nt
    v_pk_fma_f32 v[60:61], v[60:61], v[124:125], v[112:113]
    v_pk_fma_f32 v[20:21], v[20:21], v[120:121], v[96:97]
    v_pk_fma_f32 v[62:63], v[62:63], v[126:127], v[114:115]
    v_pk_fma_f32 v[22:23], v[22:23], v[122:123], v[98:99]
    v_cvt_pk_bf16_f32 v20, v60, v20
    v_cvt_pk_bf16_f32 v21, v61, v21
    v_cvt_pk_bf16_f32 v22, v62, v22
    v_cvt_pk_bf16_f32 v23, v63, v23
    global_store_dwordx4 v1, v[20:23], s[10:11] offset:1280 nt
    v_pk_fma_f32 v[64:65], v[64:65], v[124:125], v[112:113]
    v_pk_fma_f32 v[24:25], v[24:25], v[120:121], v[96:97]
    v_pk_fma_f32 v[66:67], v[66:67], v[126:127], v[114:115]
    v_pk_fma_f32 v[26:27], v[26:27], v[122:123], v[98:99]
    v_cvt_pk_bf16_f32 v24, v64, v24
    v_cvt_pk_bf16_f32 v25, v65, v25
    v_cvt_pk_bf16_f32 v26, v66, v26
    v_cvt_pk_bf16_f32 v27, v67, v27
    global_store_dwordx4 v1, v[24:27], s[10:11] offset:2560 nt
    v_pk_fma_f32 v[68:69], v[68:69], v[124:125], v[112:113]
    v_pk_fma_f32 v[28:29], v[28:29], v[120:121], v[96:97]
    v_pk_fma_f32 v[70:71], v[70:71], v[126:127], v[114:115]
    v_pk_fma_f32 v[30:31], v[30:31], v[122:123], v[98:99]
    v_cvt_pk_bf16_f32 v28, v68, v28
    v_cvt_pk_bf16_f32 v29, v69, v29
    v_cvt_pk_bf16_f32 v30, v70, v30
    v_cvt_pk_bf16_f32 v31, v71, v31
    global_store_dwordx4 v1, v[28:31], s[10:11] offset:3840 nt
    v_pk_fma_f32 v[72:73], v[72:73], v[124:125], v[112:113]
    v_pk_fma_f32 v[32:33], v[32:33], v[120:121], v[96:97]
    v_pk_fma_f32 v[74:75], v[74:75], v[126:127], v[114:115]
    v_pk_fma_f32 v[34:35], v[34:35], v[122:123], v[98:99]
    v_cvt_pk_bf16_f32 v32, v72, v32
    v_cvt_pk_bf16_f32 v33, v73, v33
    v_cvt_pk_bf16_f32 v34, v74, v34
    v_cvt_pk_bf16_f32 v35, v75, v35
    global_store_dwordx4 v2, v[32:35], s[10:11] offset:0 nt
    v_pk_fma_f32 v[76:77], v[76:77], v[124:125], v[112:113]
    v_pk_fma_f32 v[36:37], v[36:37], v[120:121], v[96:97]
    v_pk_fma_f32 v[78:79], v[78:79], v[126:127], v[114:115]
    v_pk_fma_f32 v[38:39], v[38:39], v[122:123], v[98:99]
    v_cvt_pk_bf16_f32 v36, v76, v36
    v_cvt_pk_bf16_f32 v37, v77, v37
    v_cvt_pk_bf16_f32 v38, v78, v38
    v_cvt_pk_bf16_f32 v39, v79, v39
    global_store_dwordx4 v2, v[36:39], s[10:11] offset:1280 nt
    v_pk_fma_f32 v[80:81], v[80:81], v[124:125], v[112:113]
    v_pk_fma_f32 v[40:41], v[40:41], v[120:121], v[96:97]
    v_pk_fma_f32 v[82:83], v[82:83], v[126:127], v[114:115]
    v_pk_fma_f32 v[42:43], v[42:43], v[122:123], v[98:99]
    v_cvt_pk_bf16_f32 v40, v80, v40
    v_cvt_pk_bf16_f32 v41, v81, v41
    v_cvt_pk_bf16_f32 v42, v82, v42
    v_cvt_pk_bf16_f32 v43, v83, v43
    global_store_dwordx4 v2, v[40:43], s[10:11] offset:2560 nt
    v_pk_fma_f32 v[84:85], v[84:85], v[124:125], v[112:113]
    v_pk_fma_f32 v[44:45], v[44:45], v[120:121], v[96:97]
    v_pk_fma_f32 v[86:87], v[86:87], v[126:127], v[114:115]
    v_pk_fma_f32 v[46:47], v[46:47], v[122:123], v[98:99]
    v_cvt_pk_bf16_f32 v44, v84, v44
    v_cvt_pk_bf16_f32 v45, v85, v45
    v_cvt_pk_bf16_f32 v46, v86, v46
    v_cvt_pk_bf16_f32 v47, v87, v47
L_hop2:
    s_cbranch_scc1 L_back2
    global_store_dwordx4 v2, v[44:47], s[10:11] offset:3840 nt
    v_pk_fma_f32 v[48:49], v[48:49], v[132:133], v[116:117]
    v_pk_fma_f32 v[8:9], v[8:9], v[128:129], v[100:101]
    v_pk_fma_f32 v[50:51], v[50:51], v[134:135], v[118:119]
    v_pk_fma_f32 v[10:11], v[10:11], v[130:131], v[102:103]
    v_cvt_pk_bf16_f32 v8, v48, v8
    v_cvt_pk_bf16_f32 v9, v49, v9
    v_cvt_pk_bf16_f32 v10, v50, v10
    v_cvt_pk_bf16_f32 v11, v51, v11
    global_store_dwordx4 v3, v[8:11], s[10:11] offset:-2560 nt
    v_pk_fma_f32 v[52:53], v[52:53], v[132:133], v[116:117]
    v_pk_fma_f32 v[12:13], v[12:13], v[128:129], v[100:101]
    v_pk_fma_f32 v[54:55], v[54:55], v[134:135], v[118:119]
    v_pk_fma_f32 v[14:15], v[14:15], v[130:131], v[102:103]
    v_cvt_pk_bf16_f32 v12, v52, v12
    v_cvt_pk_bf16_f32 v13, v53, v13
    v_cvt_pk_bf16_f32 v14, v54, v14
    v_cvt_pk_bf16_f32 v15, v55, v15
    global_store_dwordx4 v3, v[12:15], s[10:11] offset:2560 nt
L_end:
    s_endpgm
.section .rodata,"a"
.p2align 6
.amdhsa_kernel standalone__grn__sampling_kernel
  .amdhsa_next_free_vgpr 144
  .amdhsa_next_free_sgpr 16
  .amdhsa_accum_offset 144
  .amdhsa_group_segment_fixed_size 0
  .amdhsa_kernarg_size 48
  .amdhsa_user_sgpr_count 2
  .amdhsa_user_sgpr_kernarg_segment_ptr 1
  .amdhsa_system_sgpr_workgroup_id_x 1
  .amdhsa_float_denorm_mode_32 3
.end_amdhsa_kernel
```
